```python
import torch

def _softmax(x, axis=-1):
    return torch.softmax(x, dim=axis)
def _gelu(x):
    return torch.nn.functional.gelu(x, approximate="tanh")
def _silu(x):
    return torch.nn.functional.silu(x)
def _sigmoid(x):
    return torch.sigmoid(x)
def _layernorm(x, axis=-1, eps=1e-5):
    m = x.mean(dim=axis, keepdim=True)
    v = x.var(dim=axis, keepdim=True, unbiased=False)
    return (x - m) / torch.sqrt(v + eps)
def _scatter_add(tgt, idx, src, axis=0):
    return tgt.clone().index_add_(axis, idx, src)
def _segment_sum(src, seg, n):
    out = torch.zeros((n,) + src.shape[1:], dtype=src.dtype)
    return out.index_add_(0, seg, src)
def _pad(x, pw):
    flat = tuple(v for pair in reversed(pw) for v in pair)
    return torch.nn.functional.pad(x, flat)

kernel_name = 'recurrent_scan__sliding_block_cached__glu_gated_bilinear__decode'

def setup_inputs():

    _w = (lambda a: (lambda t: t.to(torch.bfloat16) if t.is_floating_point() else t)(torch.as_tensor(a)))
    def _A_setup():
        B, Sq, D = 8, 1, 512
        Hq, Hkv, Sk, Dh = 32, 8, 4096, 128
        assert Hq % Hkv == 0, (Hq, Hkv)
        return {
            "x": _w((lambda *s: torch.randn(*s, dtype=torch.bfloat16) * 0.05)(B, Sq, D)),
            "k_cache": _w((lambda *s: torch.randn(*s, dtype=torch.bfloat16) * 3.2)(B, Hkv, Sk, Dh)),
            "v_cache": _w((lambda *s: torch.randn(*s, dtype=torch.bfloat16) * 3.2)(B, Hkv, Sk, Dh)),
            "wq": _w((lambda *s: torch.randn(*s, dtype=torch.bfloat16) * 3.2)(D, Hq * Dh) * (D ** -0.5)),
            "wo": _w((lambda *s: torch.randn(*s, dtype=torch.bfloat16) * 3.2)(Hq * Dh, D) * ((Hq * Dh) ** -0.5)),
        }
    _A_in = _A_setup()

    def _B_setup():
        B, S, D, F = 8, 1, 512, 1792
        return {
            "x": _w((lambda *s: torch.randn(*s, dtype=torch.bfloat16) * 0.05)(B, S, D)),
            "w_gate": _w((lambda *s: torch.randn(*s, dtype=torch.bfloat16) * 0.4)(D, F) * (D ** -0.5)),
            "w_up": _w((lambda *s: torch.randn(*s, dtype=torch.bfloat16) * 0.4)(D, F) * (D ** -0.5)),
            "w_down": _w((lambda *s: torch.randn(*s, dtype=torch.bfloat16) * 0.4)(F, D) * (F ** -0.5)),
        }
    _B_in = _B_setup()

    return {
        "A_x": _A_in["x"],
        "A_k_cache": _A_in["k_cache"],
        "A_v_cache": _A_in["v_cache"],
        "A_wq": _A_in["wq"],
        "A_wo": _A_in["wo"],
        "B_x": _B_in["x"],
        "B_w_gate": _B_in["w_gate"],
        "B_w_up": _B_in["w_up"],
        "B_w_down": _B_in["w_down"],
    }

def reference(A_x, A_k_cache, A_v_cache, A_wq, A_wo, B_x, B_w_gate, B_w_up, B_w_down):
    def _A_ref(x, k_cache, v_cache, wq, wo):
        B, Sq, D = x.shape
        Hq, Dh = 32, 128
        Hkv, Sk = k_cache.shape[1], k_cache.shape[2]
        W = min(4096, max(256, Sk // 4))
        rep = Hq // Hkv
        q = (lambda x, *d: x.permute(*d))((x @ wq).reshape(B, Sq, Hq, Dh), 0, 2, 1, 3)
        k = (lambda x, n, axis: torch.repeat_interleave(x, n, dim=axis))(k_cache[:, :, Sk - W:, :], rep, axis=1)
        v = (lambda x, n, axis: torch.repeat_interleave(x, n, dim=axis))(v_cache[:, :, Sk - W:, :], rep, axis=1)
        scores = torch.einsum("bhqd,bhkd->bhqk", q, k) * (Dh ** -0.5)
        p = _softmax(scores, axis=-1)
        o = torch.einsum("bhqk,bhkd->bhqd", p, v)
        return (lambda x, *d: x.permute(*d))(o, 0, 2, 1, 3).reshape(B, Sq, Hq * Dh) @ wo

    def _B_ref(x, w_gate, w_up, w_down):
        g = torch.einsum("bsd,df->bsf", x, w_gate)
        u = torch.einsum("bsd,df->bsf", x, w_up)
        h = g * u
        return torch.einsum("bsf,fd->bsd", h, w_down)

    x = A_x
    xn = _layernorm(x, axis=-1)
    s = _A_ref(xn, A_k_cache, A_v_cache, A_wq, A_wo)
    g = _silu(_B_ref(xn, B_w_gate, B_w_up, B_w_down))
    return x + s * g
```

```asm
; @launch grid=(256,1,1) block=(512,1,1) lds=78208
.amdgcn_target "amdgcn-amd-amdhsa--gfx950"
.text
.globl recurrent_scan__sliding_block_cached__glu_gated_bilinear__decode_kernel
.p2align 8
.type recurrent_scan__sliding_block_cached__glu_gated_bilinear__decode_kernel,@function
recurrent_scan__sliding_block_cached__glu_gated_bilinear__decode_kernel:
    s_cmp_ge_u32 s2, 256
    s_cbranch_scc1 L_end
    s_load_dwordx16 s[4:19], s[0:1], 0
    s_load_dwordx8 s[20:27], s[0:1], 64
    v_lshrrev_b32 v6, 6, v0
    v_and_b32 v1, 63, v0
    v_and_b32 v2, 15, v0
    v_bfe_u32 v3, v0, 4, 2
    v_readfirstlane_b32 s68, v6
    s_add_u32 s88, s68, 0
    s_and_b32 s88, s88, 7
    s_and_b32 s69, s2, 7
    s_lshr_b32 s70, s2, 3
    s_mov_b32 s80, 0x05040100
    s_mov_b32 s81, 0x07060302
    s_mov_b32 s82, 0
    s_mov_b32 s83, 0x3db504f3
    s_mov_b32 s86, 0x3fb8aa3b
    s_and_b32 s92, s69, 1
    s_lshr_b32 s93, s69, 1
    s_lshr_b32 s78, s70, 2
    s_and_b32 s94, s70, 1
    s_sub_u32 s3, s93, s94
    s_add_u32 s3, s3, 2
    s_and_b32 s3, s3, 3
    s_lshl_b32 s79, s94, 1
    s_add_u32 s79, s79, s92
    s_bfe_u32 s94, s70, 0x10001
    s_lshl_b32 s94, s94, 2
    s_add_u32 s3, s3, s94
    s_bfe_u32 s94, s70, 0x10003
    s_sub_u32 s76, s93, s94
    s_and_b32 s76, s76, 3
    s_lshr_b32 s95, s70, 4
    s_lshl_b32 s95, s95, 2
    s_add_u32 s76, s76, s95
    s_lshl_b32 s76, s76, 2
    s_bfe_u32 s95, s70, 0x20001
    s_add_u32 s76, s76, s95
    s_lshl_b32 s77, s94, 2
    s_lshl_b32 s95, s92, 1
    s_add_u32 s77, s77, s95
    s_and_b32 s95, s70, 1
    s_add_u32 s77, s77, s95
    s_lshr_b32 s94, s93, 1
    s_lshl_b32 s94, s94, 2
    s_and_b32 s95, s93, 1
    s_add_u32 s94, s94, s95
    s_lshl_b32 s95, s92, 1
    s_add_u32 s99, s94, s95
    s_lshl_b32 s99, s99, 2
    s_and_b32 s95, s70, 3
    s_add_u32 s99, s99, s95
    s_lshr_b32 s98, s70, 2
    s_and_b32 s100, s70, 7
    s_xor_b32 s95, s92, 1
    s_lshl_b32 s95, s95, 1
    s_add_u32 s101, s94, s95
    s_lshl_b32 s101, s101, 2
    s_lshr_b32 s95, s70, 3
    s_add_u32 s101, s101, s95
    s_lshl_b32 s71, s78, 23
    s_lshl_b32 s72, s3, 20
    s_add_u32 s71, s71, s72
    s_add_u32 s89, s71, 786432
    s_lshl_b32 s71, s79, 16
    s_add_u32 s71, s71, s89
    s_lshl_b32 s72, s68, 13
    s_add_u32 s71, s71, s72
    v_lshlrev_b32 v6, 4, v1
    v_lshrrev_b32 v7, 1, v1
    v_and_b32 v8, 1, v1
    v_lshlrev_b32 v8, 4, v8
    v_lshl_add_u32 v9, v7, 13, v8
    v_lshl_add_u32 v28, v7, 10, v8
    v_mul_u32_u24 v10, 3584, v7
    v_add_u32 v10, v10, v8
    v_lshrrev_b32 v7, 3, v1
    v_and_b32 v8, 7, v1
    v_lshlrev_b32 v8, 4, v8
    v_mov_b32 v29, 74048
    v_lshrrev_b32 v7, 2, v2
    v_and_b32 v8, 3, v2
    v_lshl_add_u32 v7, v7, 3, v8
    v_lshlrev_b32 v7, 8, v7
    v_lshl_add_u32 v11, v3, 4, v7
    v_lshlrev_b32 v7, 11, v3
    v_lshl_add_u32 v30, v2, 4, v7
    v_mov_b32 v31, 0
    v_and_b32 v12, 3, v1
    v_lshlrev_b32 v12, 3, v12
    v_bfe_u32 v13, v1, 2, 1
    v_lshl_add_u32 v12, v13, 2, v12
    s_lshl_b32 s74, s100, 10
    s_lshl_b32 s72, s101, 5
    s_add_u32 s74, s74, s72
    s_lshl_b32 s72, s69, 5
    s_add_u32 s72, s72, s70
    s_lshl_b32 s72, s72, 5
    s_lshl_b32 s73, s68, 19
    s_add_u32 s72, s72, s73
    s_min_u32 s75, s70, 27
    s_cmp_ge_u32 s75, 14
    s_cselect_b32 s87, 1, 0
    s_mul_i32 s73, s87, 14
    s_sub_u32 s90, s75, s73
    s_lshl_b32 s75, s90, 5
    s_mul_i32 s73, s69, 448
    s_add_u32 s75, s75, s73
    s_mul_i32 s73, s68, 229376
    s_add_u32 s75, s75, s73
    s_lshl_b32 s91, s68, 10
    s_waitcnt lgkmcnt(0)
    s_mov_b32 s64, s26
    s_and_b32 s65, s27, 0xffff
    s_mov_b32 s66, 2695168
    s_mov_b32 s67, 0x00020000
    s_mov_b32 s28, s4
    s_and_b32 s29, s5, 0xffff
    s_mov_b32 s30, 8192
    s_mov_b32 s31, 0x00020000
    s_mov_b32 s40, s10
    s_and_b32 s41, s11, 0xffff
    s_mov_b32 s42, 4194304
    s_mov_b32 s43, 0x00020000
    s_load_dword s95, s[26:27], 0
    buffer_load_dword v5, v12, s[28:31], s74 offen
    buffer_load_dwordx4 v[20:23], v6, s[28:31], s91 offen
    s_lshl_b32 s92, s91, 1
    s_add_u32 s92, s92, 0
    s_mov_b32 m0, s92
    s_add_u32 s93, s72, 262144
    buffer_load_dwordx4 v9, s[40:43], s72 offen nt lds
    s_add_u32 s92, s92, 1024
    s_mov_b32 m0, s92
    s_mov_b32 s32, s6
    s_and_b32 s33, s7, 0xffff
    s_mov_b32 s34, 67108864
    s_mov_b32 s35, 0x00020000
    buffer_load_dwordx4 v9, s[40:43], s93 offen nt lds
    s_cmp_eq_u32 s87, 0
    s_cselect_b32 s16, s16, s18
    s_cselect_b32 s17, s17, s19
    s_mov_b32 s48, s16
    s_and_b32 s49, s17, 0xffff
    s_mov_b32 s50, 1835008
    s_mov_b32 s51, 0x00020000
    s_lshl_b32 s92, s91, 1
    s_add_u32 s92, s92, 16384
    s_mov_b32 m0, s92
    s_add_u32 s93, s75, 114688
    buffer_load_dwordx4 v10, s[48:51], s75 offen nt lds
    s_add_u32 s92, s92, 1024
    s_mov_b32 m0, s92
    s_nop 0
    buffer_load_dwordx4 v10, s[48:51], s93 offen nt lds
    s_barrier
    buffer_load_dwordx4 v[32:35], v11, s[32:35], s71 offen offset:0 nt
    buffer_load_dwordx4 v[36:39], v11, s[32:35], s71 offen offset:64 nt
    s_mov_b32 s36, s8
    s_and_b32 s37, s9, 0xffff
    s_mov_b32 s38, 67108864
    s_mov_b32 s39, 0x00020000
    s_mov_b32 s44, s12
    s_and_b32 s45, s13, 0xffff
    s_mov_b32 s46, 4194304
    s_mov_b32 s47, 0x00020000
    s_mov_b32 s56, s20
    s_and_b32 s57, s21, 0xffff
    s_mov_b32 s58, 1835008
    s_mov_b32 s59, 0x00020000
    s_mov_b32 s60, s22
    s_and_b32 s61, s23, 0xffff
    s_mov_b32 s62, 8192
    s_mov_b32 s63, 0x00020000
    s_mov_b32 s20, s89
    s_lshl_b32 s21, s3, 3
    s_add_u32 s21, s21, s78
    s_lshl_b32 s21, s21, 7
    s_add_u32 s21, s21, 2686976
    s_mov_b32 s22, 1
    s_waitcnt vmcnt(6)
    s_waitcnt lgkmcnt(0)
    s_add_u32 s95, s95, 1
    v_mov_b32 v4, s95
    v_lshlrev_b32 v12, 16, v20
    v_and_b32 v13, 0xffff0000, v20
    v_lshlrev_b32 v14, 16, v21
    v_and_b32 v15, 0xffff0000, v21
    v_lshlrev_b32 v16, 16, v22
    v_and_b32 v17, 0xffff0000, v22
    v_lshlrev_b32 v18, 16, v23
    v_and_b32 v19, 0xffff0000, v23
    v_add_f32 v20, v12, v13
    v_add_f32 v21, v14, v15
    v_add_f32 v22, v16, v17
    v_add_f32 v23, v18, v19
    v_add_f32 v20, v20, v21
    v_add_f32 v22, v22, v23
    v_add_f32 v20, v20, v22
    s_nop 1
    v_add_f32_dpp v20, v20, v20 quad_perm:[1,0,3,2] row_mask:0xf bank_mask:0xf
    s_nop 1
    v_add_f32_dpp v20, v20, v20 quad_perm:[2,3,0,1] row_mask:0xf bank_mask:0xf
    s_nop 1
    v_add_f32_dpp v20, v20, v20 row_half_mirror row_mask:0xf bank_mask:0xf
    s_nop 1
    v_add_f32_dpp v20, v20, v20 row_mirror row_mask:0xf bank_mask:0xf
    v_mov_b32 v21, v20
    s_nop 1
    v_permlane16_swap_b32 v20, v21
    v_add_f32 v20, v20, v21
    v_mov_b32 v21, v20
    s_nop 1
    v_permlane32_swap_b32 v20, v21
    v_add_f32 v20, v20, v21
    v_mul_f32 v20, 0x3b000000, v20
    v_sub_f32 v21, v12, v20
    v_mul_f32 v22, v21, v21
    v_sub_f32 v21, v13, v20
    v_fmac_f32 v22, v21, v21
    v_sub_f32 v21, v14, v20
    v_fmac_f32 v22, v21, v21
    v_sub_f32 v21, v15, v20
    v_fmac_f32 v22, v21, v21
    v_sub_f32 v21, v16, v20
    v_fmac_f32 v22, v21, v21
    v_sub_f32 v21, v17, v20
    v_fmac_f32 v22, v21, v21
    v_sub_f32 v21, v18, v20
    v_fmac_f32 v22, v21, v21
    v_sub_f32 v21, v19, v20
    v_fmac_f32 v22, v21, v21
    s_nop 1
    v_add_f32_dpp v22, v22, v22 quad_perm:[1,0,3,2] row_mask:0xf bank_mask:0xf
    s_nop 1
    v_add_f32_dpp v22, v22, v22 quad_perm:[2,3,0,1] row_mask:0xf bank_mask:0xf
    s_nop 1
    v_add_f32_dpp v22, v22, v22 row_half_mirror row_mask:0xf bank_mask:0xf
    s_nop 1
    v_add_f32_dpp v22, v22, v22 row_mirror row_mask:0xf bank_mask:0xf
    v_mov_b32 v21, v22
    s_nop 1
    v_permlane16_swap_b32 v22, v21
    v_add_f32 v22, v22, v21
    v_mov_b32 v21, v22
    s_nop 1
    v_permlane32_swap_b32 v22, v21
    v_add_f32 v22, v22, v21
    v_mul_f32 v22, 0x3b000000, v22
    v_cvt_pk_bf16_f32 v20, v20, v22
    v_and_b32 v22, 0xffff0000, v20
    v_lshlrev_b32 v20, 16, v20
    v_add_f32 v22, 0x3727c5ac, v22
    v_cvt_pk_bf16_f32 v22, v22, v22
    v_lshlrev_b32 v22, 16, v22
    v_sqrt_f32 v22, v22
    s_nop 0
    v_cvt_pk_bf16_f32 v22, v22, v22
    v_lshlrev_b32 v22, 16, v22
    v_rcp_f32 v23, v22
    v_sub_f32 v12, v12, v20
    v_sub_f32 v13, v13, v20
    v_cvt_pk_bf16_f32 v21, v12, v13
    v_lshlrev_b32 v12, 16, v21
    v_and_b32 v13, 0xffff0000, v21
    v_mul_f32 v21, v12, v23
    v_fma_f32 v24, -v21, v22, v12
    v_fma_f32 v12, v24, v23, v21
    v_mul_f32 v21, v13, v23
    v_fma_f32 v24, -v21, v22, v13
    v_fma_f32 v13, v24, v23, v21
    v_cvt_pk_bf16_f32 v96, v12, v13
    v_sub_f32 v14, v14, v20
    v_sub_f32 v15, v15, v20
    v_cvt_pk_bf16_f32 v21, v14, v15
    v_lshlrev_b32 v14, 16, v21
    v_and_b32 v15, 0xffff0000, v21
    v_mul_f32 v21, v14, v23
    v_fma_f32 v24, -v21, v22, v14
    v_fma_f32 v14, v24, v23, v21
    v_mul_f32 v21, v15, v23
    v_fma_f32 v24, -v21, v22, v15
    v_fma_f32 v15, v24, v23, v21
    v_cvt_pk_bf16_f32 v97, v14, v15
    v_sub_f32 v16, v16, v20
    v_sub_f32 v17, v17, v20
    v_cvt_pk_bf16_f32 v21, v16, v17
    v_lshlrev_b32 v16, 16, v21
    v_and_b32 v17, 0xffff0000, v21
    v_mul_f32 v21, v16, v23
    v_fma_f32 v24, -v21, v22, v16
    v_fma_f32 v16, v24, v23, v21
    v_mul_f32 v21, v17, v23
    v_fma_f32 v24, -v21, v22, v17
    v_fma_f32 v17, v24, v23, v21
    v_cvt_pk_bf16_f32 v98, v16, v17
    v_sub_f32 v18, v18, v20
    v_sub_f32 v19, v19, v20
    v_cvt_pk_bf16_f32 v21, v18, v19
    v_lshlrev_b32 v18, 16, v21
    v_and_b32 v19, 0xffff0000, v21
    v_mul_f32 v21, v18, v23
    v_fma_f32 v24, -v21, v22, v18
    v_fma_f32 v18, v24, v23, v21
    v_mul_f32 v21, v19, v23
    v_fma_f32 v24, -v21, v22, v19
    v_fma_f32 v19, v24, v23, v21
    v_cvt_pk_bf16_f32 v99, v18, v19
    s_mul_i32 s92, s68, 1088
    s_add_u32 s92, s92, 57344
    v_add_u32 v7, s92, v6
    ds_write_b128 v7, v[96:99]
    ds_write_b32 v29, v31
    ds_write_b32 v29, v31 offset:4
    s_waitcnt vmcnt(2) lgkmcnt(0)
    s_barrier
    v_and_b32 v7, 7, v2
    v_mul_u32_u24 v7, 1088, v7
    v_lshl_add_u32 v7, v3, 4, v7
    v_add_u32 v7, 57344, v7
    s_lshl_b32 s92, s68, 7
    v_add_u32 v16, s92, v7
    v_lshlrev_b32 v8, 8, v3
    v_lshl_add_u32 v8, v2, 3, v8
    s_lshl_b32 s92, s68, 11
    s_add_u32 s92, s92, 0
    v_add_u32 v8, s92, v8
    v_add_u32 v9, 16384, v8
    ds_read_b64_tr_b16 v[64:65], v8 offset:0
    ds_read_b64_tr_b16 v[66:67], v8 offset:128
    ds_read_b128 v[80:83], v16 offset:0
    ds_read_b64_tr_b16 v[68:69], v8 offset:1024
    ds_read_b64_tr_b16 v[70:71], v8 offset:1152
    ds_read_b128 v[84:87], v16 offset:64
    ds_read_b64_tr_b16 v[72:73], v9 offset:0
    ds_read_b64_tr_b16 v[74:75], v9 offset:128
    ds_read_b64_tr_b16 v[76:77], v9 offset:1024
    ds_read_b64_tr_b16 v[78:79], v9 offset:1152
    s_waitcnt lgkmcnt(4)
    v_mfma_f32_16x16x32_bf16 v[12:15], v[64:67], v[80:83], 0
    v_mfma_f32_16x16x32_bf16 v[12:15], v[68:71], v[84:87], v[12:15]
    s_waitcnt lgkmcnt(0)
    v_mfma_f32_16x16x32_bf16 v[16:19], v[72:75], v[80:83], 0
    v_mfma_f32_16x16x32_bf16 v[16:19], v[76:79], v[84:87], v[16:19]
    v_lshl_add_u32 v8, v3, 3, v2
    v_lshlrev_b32 v8, 4, v8
    v_add_u32 v8, 74112, v8
    s_lshl_b32 s92, s68, 9
    v_add_u32 v9, s92, v8
    v_cmp_gt_u32 vcc, 8, v2
    s_and_saveexec_b64 s[84:85], vcc
    s_nop 7
    ds_write_b128 v9, v[12:15]
    v_subrev_u32 v9, 7040, v9
    ds_write_b128 v9, v[16:19]
    s_mov_b64 exec, s[84:85]
    s_waitcnt lgkmcnt(0)
    s_barrier
    s_cmp_gt_u32 s68, 1
    s_cbranch_scc1 L_p3
    s_mul_i32 s92, s68, 7040
    v_subrev_u32 v8, s92, v8
    v_cmp_gt_u32 vcc, 8, v2
    s_and_saveexec_b64 s[84:85], vcc
    ds_read_b128 v[64:67], v8 offset:0
    ds_read_b128 v[68:71], v8 offset:512
    ds_read_b128 v[72:75], v8 offset:1024
    ds_read_b128 v[76:79], v8 offset:1536
    ds_read_b128 v[80:83], v8 offset:2048
    ds_read_b128 v[84:87], v8 offset:2560
    ds_read_b128 v[88:91], v8 offset:3072
    ds_read_b128 v[92:95], v8 offset:3584
    s_cmp_eq_u32 s68, 1
    s_cbranch_scc1 L_p2g
    v_lshlrev_b32 v8, 14, v2
    s_lshl_b32 s92, s69, 5
    s_add_u32 s92, s92, s70
    s_lshl_b32 s92, s92, 6
    s_add_u32 s92, s92, 4096
    s_branch L_p2j
L_p2g:
    v_mul_u32_u24 v8, 7168, v2
    s_mul_i32 s92, s87, 57344
    s_mul_i32 s93, s69, 896
    s_add_u32 s92, s92, s93
    s_lshl_b32 s93, s90, 6
    s_add_u32 s92, s92, s93
    s_add_u32 s92, s92, 135168
    s_cmp_lt_u32 s70, 28
    s_cbranch_scc1 L_p2j
    s_waitcnt lgkmcnt(0)
    s_mov_b64 exec, s[84:85]
    s_branch L_p3
L_p2j:
    v_lshl_add_u32 v8, v3, 4, v8
    s_waitcnt lgkmcnt(0)
    v_add_f32 v64, v64, v68
    v_add_f32 v65, v65, v69
    v_add_f32 v66, v66, v70
    v_add_f32 v67, v67, v71
    v_add_f32 v64, v64, v72
    v_add_f32 v65, v65, v73
    v_add_f32 v66, v66, v74
    v_add_f32 v67, v67, v75
    v_add_f32 v64, v64, v76
    v_add_f32 v65, v65, v77
    v_add_f32 v66, v66, v78
    v_add_f32 v67, v67, v79
    v_add_f32 v64, v64, v80
    v_add_f32 v65, v65, v81
    v_add_f32 v66, v66, v82
    v_add_f32 v67, v67, v83
    v_add_f32 v64, v64, v84
    v_add_f32 v65, v65, v85
    v_add_f32 v66, v66, v86
    v_add_f32 v67, v67, v87
    v_add_f32 v64, v64, v88
    v_add_f32 v65, v65, v89
    v_add_f32 v66, v66, v90
    v_add_f32 v67, v67, v91
    v_add_f32 v64, v64, v92
    v_add_f32 v65, v65, v93
    v_add_f32 v66, v66, v94
    v_add_f32 v67, v67, v95
    v_cvt_pk_bf16_f32 v16, v64, v65
    v_cvt_pk_bf16_f32 v18, v66, v67
    v_mov_b32 v17, v4
    v_mov_b32 v19, v4
    buffer_store_dwordx4 v[16:19], v8, s[64:67], s92 offen sc1
    s_mov_b64 exec, s[84:85]
L_p3:
    s_cmp_ge_u32 s68, 8
    s_cbranch_scc1 L_p3x
    buffer_load_dwordx4 v[40:43], v11, s[32:35], s71 offen offset:128 nt
    buffer_load_dwordx4 v[44:47], v11, s[32:35], s71 offen offset:192 nt
    buffer_load_dwordx4 v[48:51], v11, s[32:35], s71 offen offset:1024 nt
    buffer_load_dwordx4 v[52:55], v11, s[32:35], s71 offen offset:1088 nt
    buffer_load_dwordx4 v[56:59], v11, s[32:35], s71 offen offset:1152 nt
    buffer_load_dwordx4 v[60:63], v11, s[32:35], s71 offen offset:1216 nt
    buffer_load_dwordx4 v[64:67], v30, s[36:39], s71 offen offset:0 nt
    buffer_load_dwordx4 v[68:71], v30, s[36:39], s71 offen offset:256 nt
    buffer_load_dwordx4 v[72:75], v30, s[36:39], s71 offen offset:512 nt
    buffer_load_dwordx4 v[76:79], v30, s[36:39], s71 offen offset:768 nt
    buffer_load_dwordx4 v[80:83], v30, s[36:39], s71 offen offset:1024 nt
    buffer_load_dwordx4 v[84:87], v30, s[36:39], s71 offen offset:1280 nt
    buffer_load_dwordx4 v[88:91], v30, s[36:39], s71 offen offset:1536 nt
    buffer_load_dwordx4 v[92:95], v30, s[36:39], s71 offen offset:1792 nt
    s_cmp_gt_u32 s88, 4
    s_cbranch_scc1 L_txa
    s_cmp_eq_u32 s88, 4
    s_cbranch_scc1 L_tda
    s_lshl_b32 s92, s76, 17
    s_lshl_b32 s93, s77, 7
    s_add_u32 s92, s92, s93
    s_lshl_b32 s93, s88, 5
    s_add_u32 s92, s92, s93
    s_lshl_b32 s93, s88, 12
    s_add_u32 s93, s93, 32768
    s_mov_b32 m0, s93
    s_add_u32 s93, s93, 1024
    buffer_load_dwordx4 v28, s[44:47], s92 offen nt lds
    s_add_u32 s92, s92, 32768
    s_mov_b32 m0, s93
    s_add_u32 s93, s93, 1024
    buffer_load_dwordx4 v28, s[44:47], s92 offen nt lds
    s_add_u32 s92, s92, 32768
    s_mov_b32 m0, s93
    s_add_u32 s93, s93, 1024
    buffer_load_dwordx4 v28, s[44:47], s92 offen nt lds
    s_add_u32 s92, s92, 32768
    s_mov_b32 m0, s93
    s_add_u32 s93, s93, 1024
    buffer_load_dwordx4 v28, s[44:47], s92 offen nt lds
    s_add_u32 s92, s92, 32768
    s_branch L_txa
L_tda:
    s_mul_i32 s92, s98, 229376
    s_lshl_b32 s93, s99, 5
    s_add_u32 s92, s92, s93
    s_mov_b32 s93, 49152
    s_mov_b32 m0, s93
    s_add_u32 s93, s93, 1024
    buffer_load_dwordx4 v28, s[56:59], s92 offen nt lds
    s_add_u32 s92, s92, 32768
    s_mov_b32 m0, s93
    s_add_u32 s93, s93, 1024
    buffer_load_dwordx4 v28, s[56:59], s92 offen nt lds
    s_add_u32 s92, s92, 32768
    s_mov_b32 m0, s93
    s_add_u32 s93, s93, 1024
    buffer_load_dwordx4 v28, s[56:59], s92 offen nt lds
    s_add_u32 s92, s92, 32768
    s_mov_b32 m0, s93
    s_add_u32 s93, s93, 1024
    buffer_load_dwordx4 v28, s[56:59], s92 offen nt lds
    s_add_u32 s92, s92, 32768
    s_mov_b32 m0, s93
    s_add_u32 s93, s93, 1024
    buffer_load_dwordx4 v28, s[56:59], s92 offen nt lds
    s_add_u32 s92, s92, 32768
    s_mov_b32 m0, s93
    s_add_u32 s93, s93, 1024
    buffer_load_dwordx4 v28, s[56:59], s92 offen nt lds
    s_add_u32 s92, s92, 32768
    s_mov_b32 m0, s93
    s_add_u32 s93, s93, 1024
    buffer_load_dwordx4 v28, s[56:59], s92 offen nt lds
    s_add_u32 s92, s92, 32768
L_txa:
L_p3x:
    s_cmp_gt_u32 s68, 8
    s_cbranch_scc1 L_b3
    s_cmp_lg_u32 s68, 2
    s_cbranch_scc1 L_qf
    s_lshl_b32 s92, s78, 14
    s_lshl_b32 s93, s3, 11
    s_add_u32 s92, s92, s93
    s_add_u32 s92, s92, 4096
    v_lshlrev_b32 v8, 5, v1
L_qretry:
    buffer_load_dwordx4 v[12:15], v8, s[64:67], s92 offen sc1
    buffer_load_dwordx4 v[16:19], v8, s[64:67], s92 offen offset:16 sc1
    s_waitcnt vmcnt(0)
    v_min_u32 v20, v13, v15
    v_max_u32 v21, v13, v15
    v_min3_u32 v20, v20, v17, v19
    v_max3_u32 v21, v21, v17, v19
    v_xor_b32 v20, v20, v4
    v_xor_b32 v21, v21, v4
    v_or_b32 v20, v20, v21
    v_cmp_ne_u32 vcc, 0, v20
    s_cbranch_vccz L_qretry_ok
    s_add_u32 s82, s82, 1
    s_cmp_lt_u32 s82, 1000000
    s_cbranch_scc1 L_qretry
L_qretry_ok:
    v_mov_b32 v20, v12
    v_mov_b32 v21, v14
    v_mov_b32 v22, v16
    v_mov_b32 v23, v18
    v_mov_b32 v9, 1
    v_add_u32 v8, 66048, v6
    ds_write_b128 v8, v[20:23]
    s_waitcnt lgkmcnt(0)
    ds_write_b32 v29, v9
L_qf:
    ds_read_b32 v12, v29
    s_waitcnt lgkmcnt(0)
    v_readfirstlane_b32 s92, v12
    s_add_u32 s82, s82, 1
    s_cmp_eq_u32 s92, 1
    s_cbranch_scc1 L_qf_ok
    s_cmp_lt_u32 s82, 16000000
    s_cbranch_scc1 L_qf
L_qf_ok:
    s_mov_b32 s82, 0
    v_and_b32 v9, 3, v2
    v_lshlrev_b32 v9, 8, v9
    v_lshl_add_u32 v9, v3, 4, v9
    v_add_u32 v9, 66048, v9
    ds_read_b128 v[96:99], v9 offset:0
    ds_read_b128 v[100:103], v9 offset:64
    ds_read_b128 v[104:107], v9 offset:128
    ds_read_b128 v[108:111], v9 offset:192
    s_cmp_gt_u32 s88, 4
    s_cbranch_scc1 L_wv0_a
    s_cmp_eq_u32 s88, 4
    s_cbranch_scc1 L_wv0_b
    s_waitcnt vmcnt(12)
    s_branch L_wv0_c
L_wv0_b:
    s_waitcnt vmcnt(15)
    s_branch L_wv0_c
L_wv0_a:
    s_waitcnt vmcnt(8)
L_wv0_c:
    s_waitcnt lgkmcnt(0)
    v_mfma_f32_16x16x32_bf16 v[112:115], v[32:35], v[96:99], 0
    v_mfma_f32_16x16x32_bf16 v[112:115], v[36:39], v[100:103], v[112:115]
    v_mfma_f32_16x16x32_bf16 v[112:115], v[40:43], v[104:107], v[112:115]
    v_mfma_f32_16x16x32_bf16 v[112:115], v[44:47], v[108:111], v[112:115]
    v_mfma_f32_16x16x32_bf16 v[116:119], v[48:51], v[96:99], 0
    v_mfma_f32_16x16x32_bf16 v[116:119], v[52:55], v[100:103], v[116:119]
    v_mfma_f32_16x16x32_bf16 v[116:119], v[56:59], v[104:107], v[116:119]
    v_mfma_f32_16x16x32_bf16 v[116:119], v[60:63], v[108:111], v[116:119]
    s_nop 7
    s_nop 1
    v_cvt_pk_bf16_f32 v20, v112, v113
    v_cvt_pk_bf16_f32 v21, v114, v115
    v_cvt_pk_bf16_f32 v22, v116, v117
    v_cvt_pk_bf16_f32 v23, v118, v119
    v_lshlrev_b32 v12, 16, v20
    v_and_b32 v13, 0xffff0000, v20
    v_lshlrev_b32 v14, 16, v21
    v_and_b32 v15, 0xffff0000, v21
    v_lshlrev_b32 v16, 16, v22
    v_and_b32 v17, 0xffff0000, v22
    v_lshlrev_b32 v18, 16, v23
    v_and_b32 v19, 0xffff0000, v23
    v_mul_f32 v12, s83, v12
    v_mul_f32 v13, s83, v13
    v_mul_f32 v14, s83, v14
    v_mul_f32 v15, s83, v15
    v_mul_f32 v16, s83, v16
    v_mul_f32 v17, s83, v17
    v_mul_f32 v18, s83, v18
    v_mul_f32 v19, s83, v19
    v_cvt_pk_bf16_f32 v20, v12, v13
    v_cvt_pk_bf16_f32 v21, v14, v15
    v_cvt_pk_bf16_f32 v22, v16, v17
    v_cvt_pk_bf16_f32 v23, v18, v19
    v_lshlrev_b32 v12, 16, v20
    v_and_b32 v13, 0xffff0000, v20
    v_lshlrev_b32 v14, 16, v21
    v_and_b32 v15, 0xffff0000, v21
    v_lshlrev_b32 v16, 16, v22
    v_and_b32 v17, 0xffff0000, v22
    v_lshlrev_b32 v18, 16, v23
    v_and_b32 v19, 0xffff0000, v23
    v_max3_f32 v20, v12, v13, v14
    v_max3_f32 v20, v20, v15, v16
    v_max3_f32 v20, v20, v17, v18
    v_max_f32 v20, v20, v19
    v_mov_b32 v21, v20
    s_nop 1
    v_permlane16_swap_b32 v20, v21
    v_max_f32 v20, v20, v21
    v_mov_b32 v21, v20
    s_nop 1
    v_permlane32_swap_b32 v20, v21
    v_max_f32 v20, v20, v21
    v_sub_f32 v12, v12, v20
    v_sub_f32 v13, v13, v20
    v_sub_f32 v14, v14, v20
    v_sub_f32 v15, v15, v20
    v_sub_f32 v16, v16, v20
    v_sub_f32 v17, v17, v20
    v_sub_f32 v18, v18, v20
    v_sub_f32 v19, v19, v20
    v_mul_f32 v12, s86, v12
    v_mul_f32 v13, s86, v13
    v_mul_f32 v14, s86, v14
    v_mul_f32 v15, s86, v15
    v_mul_f32 v16, s86, v16
    v_mul_f32 v17, s86, v17
    v_mul_f32 v18, s86, v18
    v_mul_f32 v19, s86, v19
    v_exp_f32 v12, v12
    v_exp_f32 v13, v13
    v_exp_f32 v14, v14
    v_exp_f32 v15, v15
    v_exp_f32 v16, v16
    v_exp_f32 v17, v17
    v_exp_f32 v18, v18
    v_exp_f32 v19, v19
    s_nop 0
    v_add_f32 v22, v12, v13
    v_add_f32 v23, v14, v15
    v_add_f32 v22, v22, v16
    v_add_f32 v23, v23, v17
    v_add_f32 v22, v22, v18
    v_add_f32 v23, v23, v19
    v_add_f32 v22, v22, v23
    v_mov_b32 v21, v22
    s_nop 1
    v_permlane16_swap_b32 v22, v21
    v_add_f32 v22, v22, v21
    v_mov_b32 v21, v22
    s_nop 1
    v_permlane32_swap_b32 v22, v21
    v_add_f32 v22, v22, v21
    v_cvt_pk_bf16_f32 v24, v12, v13
    v_cvt_pk_bf16_f32 v25, v14, v15
    v_cvt_pk_bf16_f32 v26, v16, v17
    v_cvt_pk_bf16_f32 v27, v18, v19
    s_lshl_b32 s92, s68, 11
    s_add_u32 s92, s92, 0
    v_lshlrev_b32 v9, 9, v2
    v_lshl_add_u32 v9, v3, 7, v9
    v_add_u32 v9, s92, v9
    s_lshl_b32 s92, s68, 2
    s_add_u32 s92, s92, 73472
    v_lshlrev_b32 v10, 5, v2
    v_add_u32 v10, s92, v10
    s_cmp_gt_u32 s88, 4
    s_cbranch_scc1 L_wv1_a
    s_cmp_eq_u32 s88, 4
    s_cbranch_scc1 L_wv1_b
    s_waitcnt vmcnt(4)
    s_branch L_wv1_c
L_wv1_b:
    s_waitcnt vmcnt(7)
    s_branch L_wv1_c
L_wv1_a:
    s_waitcnt vmcnt(0)
L_wv1_c:
    v_perm_b32 v32, v68, v64, s80
    v_perm_b32 v33, v76, v72, s80
    v_perm_b32 v34, v84, v80, s80
    v_perm_b32 v35, v92, v88, s80
    v_perm_b32 v36, v68, v64, s81
    v_perm_b32 v37, v76, v72, s81
    v_perm_b32 v38, v84, v80, s81
    v_perm_b32 v39, v92, v88, s81
    v_perm_b32 v40, v69, v65, s80
    v_perm_b32 v41, v77, v73, s80
    v_perm_b32 v42, v85, v81, s80
    v_perm_b32 v43, v93, v89, s80
    v_perm_b32 v44, v69, v65, s81
    v_perm_b32 v45, v77, v73, s81
    v_perm_b32 v46, v85, v81, s81
    v_perm_b32 v47, v93, v89, s81
    v_perm_b32 v48, v70, v66, s80
    v_perm_b32 v49, v78, v74, s80
    v_perm_b32 v50, v86, v82, s80
    v_perm_b32 v51, v94, v90, s80
    v_perm_b32 v52, v70, v66, s81
    v_perm_b32 v53, v78, v74, s81
    v_perm_b32 v54, v86, v82, s81
    v_perm_b32 v55, v94, v90, s81
    v_perm_b32 v56, v71, v67, s80
    v_perm_b32 v57, v79, v75, s80
    v_perm_b32 v58, v87, v83, s80
    v_perm_b32 v59, v95, v91, s80
    v_perm_b32 v60, v71, v67, s81
    v_perm_b32 v61, v79, v75, s81
    v_perm_b32 v62, v87, v83, s81
    v_perm_b32 v63, v95, v91, s81
    s_nop 1
    v_mfma_f32_16x16x32_bf16 v[64:67], v[32:35], v[24:27], 0
    v_mfma_f32_16x16x32_bf16 v[68:71], v[36:39], v[24:27], 0
    v_mfma_f32_16x16x32_bf16 v[72:75], v[40:43], v[24:27], 0
    v_mfma_f32_16x16x32_bf16 v[76:79], v[44:47], v[24:27], 0
    v_mfma_f32_16x16x32_bf16 v[80:83], v[48:51], v[24:27], 0
    v_mfma_f32_16x16x32_bf16 v[84:87], v[52:55], v[24:27], 0
    v_mfma_f32_16x16x32_bf16 v[88:91], v[56:59], v[24:27], 0
    v_mfma_f32_16x16x32_bf16 v[92:95], v[60:63], v[24:27], 0
    v_cmp_gt_u32 vcc, 4, v2
    s_and_saveexec_b64 s[84:85], vcc
    ds_write_b32 v10, v20
    ds_write_b32 v10, v22 offset:128
    s_nop 7
    ds_write_b128 v9, v[64:67] offset:0
    ds_write_b128 v9, v[68:71] offset:16
    ds_write_b128 v9, v[72:75] offset:32
    ds_write_b128 v9, v[76:79] offset:48
    ds_write_b128 v9, v[80:83] offset:64
    ds_write_b128 v9, v[84:87] offset:80
    ds_write_b128 v9, v[88:91] offset:96
    ds_write_b128 v9, v[92:95] offset:112
    s_mov_b64 exec, s[84:85]
L_b3:
    s_waitcnt lgkmcnt(0)
    s_barrier
    s_cmp_ge_u32 s68, 4
    s_cbranch_scc1 L_p8
    s_lshl_b32 s92, s68, 9
    s_add_u32 s92, s92, 0
    v_lshlrev_b32 v9, 7, v3
    v_and_b32 v10, 3, v1
    v_lshl_add_u32 v9, v10, 5, v9
    v_bfe_u32 v10, v1, 2, 2
    v_lshl_add_u32 v9, v10, 2, v9
    v_add_u32 v9, s92, v9
    s_lshl_b32 s92, s68, 5
    s_add_u32 s92, s92, 73472
    v_mov_b32 v10, s92
    ds_read_b128 v[32:35], v10
    ds_read_b128 v[36:39], v10 offset:16
    ds_read_b128 v[40:43], v10 offset:128
    ds_read_b128 v[44:47], v10 offset:144
    ds_read_b32 v48, v9 offset:0
    ds_read_b32 v49, v9 offset:16
    ds_read_b32 v50, v9 offset:2048
    ds_read_b32 v51, v9 offset:2064
    ds_read_b32 v52, v9 offset:4096
    ds_read_b32 v53, v9 offset:4112
    ds_read_b32 v54, v9 offset:6144
    ds_read_b32 v55, v9 offset:6160
    ds_read_b32 v56, v9 offset:8192
    ds_read_b32 v57, v9 offset:8208
    s_waitcnt lgkmcnt(10)
    v_max3_f32 v12, v32, v33, v34
    v_max3_f32 v12, v12, v35, v36
    v_max_f32 v12, v12, v37
    v_max_f32 v12, v12, v38
    v_max_f32 v12, v12, v39
    v_sub_f32 v32, v32, v12
    v_sub_f32 v33, v33, v12
    v_sub_f32 v34, v34, v12
    v_sub_f32 v35, v35, v12
    v_sub_f32 v36, v36, v12
    v_sub_f32 v37, v37, v12
    v_sub_f32 v38, v38, v12
    v_sub_f32 v39, v39, v12
    v_mul_f32 v32, s86, v32
    v_mul_f32 v33, s86, v33
    v_mul_f32 v34, s86, v34
    v_mul_f32 v35, s86, v35
    v_mul_f32 v36, s86, v36
    v_mul_f32 v37, s86, v37
    v_mul_f32 v38, s86, v38
    v_mul_f32 v39, s86, v39
    v_exp_f32 v32, v32
    v_exp_f32 v33, v33
    v_exp_f32 v34, v34
    v_exp_f32 v35, v35
    v_exp_f32 v36, v36
    v_exp_f32 v37, v37
    v_exp_f32 v38, v38
    v_exp_f32 v39, v39
    s_waitcnt lgkmcnt(4)
    ds_read_b32 v58, v9 offset:10240
    ds_read_b32 v59, v9 offset:10256
    ds_read_b32 v60, v9 offset:12288
    ds_read_b32 v61, v9 offset:12304
    ds_read_b32 v62, v9 offset:14336
    ds_read_b32 v63, v9 offset:14352
    v_mul_f32 v14, v32, v40
    v_fmac_f32 v14, v33, v41
    v_fmac_f32 v14, v34, v42
    v_fmac_f32 v14, v35, v43
    v_fmac_f32 v14, v36, v44
    v_fmac_f32 v14, v37, v45
    v_fmac_f32 v14, v38, v46
    v_fmac_f32 v14, v39, v47
    s_waitcnt lgkmcnt(0)
    v_mul_f32 v16, v32, v48
    v_mul_f32 v18, v32, v49
    v_fmac_f32 v16, v33, v50
    v_fmac_f32 v18, v33, v51
    v_fmac_f32 v16, v34, v52
    v_fmac_f32 v18, v34, v53
    v_fmac_f32 v16, v35, v54
    v_fmac_f32 v18, v35, v55
    v_fmac_f32 v16, v36, v56
    v_fmac_f32 v18, v36, v57
    v_fmac_f32 v16, v37, v58
    v_fmac_f32 v18, v37, v59
    v_fmac_f32 v16, v38, v60
    v_fmac_f32 v18, v38, v61
    v_fmac_f32 v16, v39, v62
    v_fmac_f32 v18, v39, v63
    v_mov_b32 v13, v4
    v_mov_b32 v15, v4
    v_mov_b32 v17, v4
    v_mov_b32 v19, v4
    s_lshl_b32 s92, s3, 2
    s_add_u32 s92, s92, s68
    s_lshl_b32 s92, s92, 3
    s_add_u32 s92, s92, s78
    s_lshl_b32 s92, s92, 2
    s_add_u32 s92, s92, s79
    s_lshl_b32 s93, s92, 10
    s_add_u32 s93, s93, 262144
    s_lshl_b32 s92, s92, 4
    s_add_u32 s92, s92, 1310720
    buffer_store_dwordx4 v[16:19], v6, s[64:67], s93 offen sc1
    s_mov_b64 exec, 1
    buffer_store_dwordx4 v[12:15], v31, s[64:67], s92 offen sc1
    s_mov_b64 exec, -1
L_p8:
    s_lshl_b32 s92, s76, 3
    s_add_u32 s92, s92, s68
    s_lshl_b32 s93, s92, 12
    s_add_u32 s93, s93, 262144
    s_lshl_b32 s92, s92, 6
    s_add_u32 s92, s92, 1310720
    s_mul_i32 s94, s68, 7168
    s_mul_i32 s95, s98, 896
    s_add_u32 s94, s94, s95
    s_add_u32 s94, s94, 135168
    v_min_u32 v9, 55, v1
    v_lshlrev_b32 v10, 4, v9
    v_add_u32 v11, 57344, v10
    v_and_b32 v18, 3, v1
    v_lshlrev_b32 v18, 4, v18
    buffer_load_dwordx4 v[64:67], v10, s[64:67], s94 offen sc1
    buffer_load_dwordx4 v[68:71], v11, s[64:67], s94 offen sc1
    buffer_load_dwordx4 v[48:51], v18, s[64:67], s92 offen sc1
    s_mov_b32 s95, 0
    s_mov_b32 s89, 0
    s_cmp_gt_u32 s88, 4
    s_cbranch_scc1 L_mchk
    v_lshlrev_b32 v8, 8, v3
    v_lshl_add_u32 v8, v2, 3, v8
    s_lshl_b32 s90, s88, 12
    s_add_u32 s90, s90, 32768
    v_add_u32 v8, s90, v8
    s_waitcnt vmcnt(3)
    ds_read_b64_tr_b16 v[96:97], v8 offset:0
    ds_read_b64_tr_b16 v[98:99], v8 offset:128
    ds_read_b64_tr_b16 v[100:101], v8 offset:1024
    ds_read_b64_tr_b16 v[102:103], v8 offset:1152
    ds_read_b64_tr_b16 v[104:105], v8 offset:2048
    ds_read_b64_tr_b16 v[106:107], v8 offset:2176
    ds_read_b64_tr_b16 v[108:109], v8 offset:3072
    ds_read_b64_tr_b16 v[110:111], v8 offset:3200
    ds_read_b64_tr_b16 v[112:113], v8 offset:4096
    ds_read_b64_tr_b16 v[114:115], v8 offset:4224
    ds_read_b64_tr_b16 v[116:117], v8 offset:5120
    ds_read_b64_tr_b16 v[118:119], v8 offset:5248
    ds_read_b64_tr_b16 v[120:121], v8 offset:6144
    ds_read_b64_tr_b16 v[122:123], v8 offset:6272
L_mchk:
    s_waitcnt vmcnt(0) lgkmcnt(0)
    v_xor_b32 v12, v49, v4
    v_xor_b32 v13, v51, v4
    v_or_b32 v12, v12, v13
    v_cmp_eq_u32 vcc, 0, v12
    s_and_b32 s90, vcc_lo, 15
    s_andn2_b32 s90, s90, s95
    s_or_b32 s95, s95, s90
    s_andn2_b32 s90, s90, s89
    s_bitcmp0_b32 s90, 0
    s_cbranch_scc1 L_msk0
    buffer_load_dwordx4 v[32:35], v6, s[64:67], s93 offen offset:0 sc1
L_msk0:
    s_bitcmp0_b32 s90, 1
    s_cbranch_scc1 L_msk1
    buffer_load_dwordx4 v[36:39], v6, s[64:67], s93 offen offset:1024 sc1
L_msk1:
    s_bitcmp0_b32 s90, 2
    s_cbranch_scc1 L_msk2
    buffer_load_dwordx4 v[40:43], v6, s[64:67], s93 offen offset:2048 sc1
L_msk2:
    s_bitcmp0_b32 s90, 3
    s_cbranch_scc1 L_msk3
    buffer_load_dwordx4 v[44:47], v6, s[64:67], s93 offen offset:3072 sc1
L_msk3:
    s_cmp_eq_u32 s95, 15
    s_cbranch_scc1 L_ochk
    s_add_u32 s82, s82, 1
    s_cmp_ge_u32 s82, 1000000
    s_cbranch_scc1 L_ochk
    buffer_load_dwordx4 v[48:51], v18, s[64:67], s92 offen sc1
    s_andn2_b32 s89, 15, s95
    s_bcnt1_i32_b32 s90, s89
    s_cmp_eq_u32 s90, 99
    s_cselect_b32 s89, s89, 0
    s_bitcmp0_b32 s89, 0
    s_cbranch_scc1 L_ssk0
    buffer_load_dwordx4 v[32:35], v6, s[64:67], s93 offen offset:0 sc1
L_ssk0:
    s_bitcmp0_b32 s89, 1
    s_cbranch_scc1 L_ssk1
    buffer_load_dwordx4 v[36:39], v6, s[64:67], s93 offen offset:1024 sc1
L_ssk1:
    s_bitcmp0_b32 s89, 2
    s_cbranch_scc1 L_ssk2
    buffer_load_dwordx4 v[40:43], v6, s[64:67], s93 offen offset:2048 sc1
L_ssk2:
    s_bitcmp0_b32 s89, 3
    s_cbranch_scc1 L_ssk3
    buffer_load_dwordx4 v[44:47], v6, s[64:67], s93 offen offset:3072 sc1
L_ssk3:
    s_branch L_mchk
L_ochk:
    s_waitcnt vmcnt(0)
    v_xor_b32 v12, v33, v4
    v_xor_b32 v13, v35, v4
    v_or_b32 v12, v12, v13
    v_xor_b32 v13, v37, v4
    v_or_b32 v12, v12, v13
    v_xor_b32 v13, v39, v4
    v_or_b32 v12, v12, v13
    v_xor_b32 v13, v41, v4
    v_or_b32 v12, v12, v13
    v_xor_b32 v13, v43, v4
    v_or_b32 v12, v12, v13
    v_xor_b32 v13, v45, v4
    v_or_b32 v12, v12, v13
    v_xor_b32 v13, v47, v4
    v_or_b32 v12, v12, v13
    v_xor_b32 v13, v65, v4
    v_or_b32 v12, v12, v13
    v_xor_b32 v13, v67, v4
    v_or_b32 v12, v12, v13
    v_xor_b32 v13, v69, v4
    v_or_b32 v12, v12, v13
    v_xor_b32 v13, v71, v4
    v_or_b32 v12, v12, v13
    v_cmp_ne_u32 vcc, 0, v12
    s_cbranch_vccz L_ook
    s_add_u32 s82, s82, 1
    s_cmp_ge_u32 s82, 1000000
    s_cbranch_scc1 L_ook
    buffer_load_dwordx4 v[32:35], v6, s[64:67], s93 offen offset:0 sc1
    buffer_load_dwordx4 v[36:39], v6, s[64:67], s93 offen offset:1024 sc1
    buffer_load_dwordx4 v[40:43], v6, s[64:67], s93 offen offset:2048 sc1
    buffer_load_dwordx4 v[44:47], v6, s[64:67], s93 offen offset:3072 sc1
    buffer_load_dwordx4 v[64:67], v10, s[64:67], s94 offen sc1
    buffer_load_dwordx4 v[68:71], v11, s[64:67], s94 offen sc1
    s_branch L_ochk
L_ook:
    v_readlane_b32 s8, v48, 0
    v_readlane_b32 s12, v50, 0
    v_readlane_b32 s9, v48, 1
    v_readlane_b32 s13, v50, 1
    v_readlane_b32 s10, v48, 2
    v_readlane_b32 s14, v50, 2
    v_readlane_b32 s11, v48, 3
    v_readlane_b32 s15, v50, 3
    s_nop 1
    v_mov_b32 v48, s8
    v_mov_b32 v50, s12
    v_mov_b32 v52, s9
    v_mov_b32 v54, s13
    v_mov_b32 v56, s10
    v_mov_b32 v58, s14
    v_mov_b32 v60, s11
    v_mov_b32 v62, s15
    v_max3_f32 v12, v48, v52, v56
    v_max_f32 v12, v12, v60
    v_sub_f32 v48, v48, v12
    v_sub_f32 v52, v52, v12
    v_sub_f32 v56, v56, v12
    v_sub_f32 v60, v60, v12
    v_mul_f32 v48, s86, v48
    v_mul_f32 v52, s86, v52
    v_mul_f32 v56, s86, v56
    v_mul_f32 v60, s86, v60
    v_exp_f32 v48, v48
    v_exp_f32 v52, v52
    v_exp_f32 v56, v56
    v_exp_f32 v60, v60
    v_lshlrev_b32 v72, 16, v64
    v_and_b32 v73, 0xffff0000, v64
    v_lshlrev_b32 v74, 16, v66
    v_and_b32 v75, 0xffff0000, v66
    v_lshlrev_b32 v76, 16, v68
    v_and_b32 v77, 0xffff0000, v68
    v_lshlrev_b32 v78, 16, v70
    v_and_b32 v79, 0xffff0000, v70
    v_mul_f32 v72, v72, v76
    v_mul_f32 v73, v73, v77
    v_mul_f32 v74, v74, v78
    v_mul_f32 v75, v75, v79
    v_cvt_pk_bf16_f32 v64, v72, v73
    v_cvt_pk_bf16_f32 v65, v74, v75
    v_mul_f32 v13, v48, v50
    v_mul_f32 v14, v48, v32
    v_mul_f32 v15, v48, v34
    v_fmac_f32 v13, v52, v54
    v_fmac_f32 v14, v52, v36
    v_fmac_f32 v15, v52, v38
    v_fmac_f32 v13, v56, v58
    v_fmac_f32 v14, v56, v40
    v_fmac_f32 v15, v56, v42
    v_fmac_f32 v13, v60, v62
    v_fmac_f32 v14, v60, v44
    v_fmac_f32 v15, v60, v46
    v_rcp_f32 v16, v13
    s_mul_i32 s92, s68, 528
    s_add_u32 s92, s92, 67072
    v_lshlrev_b32 v9, 3, v9
    v_add_u32 v9, s92, v9
    ds_write_b64 v9, v[64:65]
    v_mul_f32 v17, v14, v16
    v_fma_f32 v18, -v17, v13, v14
    v_fma_f32 v14, v18, v16, v17
    v_mul_f32 v17, v15, v16
    v_fma_f32 v18, -v17, v13, v15
    v_fma_f32 v15, v18, v16, v17
    v_cvt_pk_bf16_f32 v14, v14, v15
    s_mul_i32 s92, s68, 272
    s_add_u32 s92, s92, 71296
    v_lshlrev_b32 v9, 2, v1
    v_add_u32 v9, s92, v9
    ds_write_b32 v9, v14
    s_waitcnt lgkmcnt(0)
    s_barrier
    s_cmp_gt_u32 s88, 4
    s_cbranch_scc1 L_done
    v_and_b32 v9, 7, v2
    s_cmp_eq_u32 s88, 4
    s_cbranch_scc1 L_p9e
    v_mul_u32_u24 v7, 272, v9
    v_lshl_add_u32 v7, v3, 4, v7
    v_add_u32 v7, 71296, v7
    ds_read_b128 v[64:67], v7 offset:0
    ds_read_b128 v[68:71], v7 offset:64
    ds_read_b128 v[72:75], v7 offset:128
    ds_read_b128 v[76:79], v7 offset:192
    s_waitcnt lgkmcnt(3)
    v_mfma_f32_16x16x32_bf16 v[12:15], v[96:99], v[64:67], 0
    s_waitcnt lgkmcnt(2)
    v_mfma_f32_16x16x32_bf16 v[12:15], v[100:103], v[68:71], v[12:15]
    s_waitcnt lgkmcnt(1)
    v_mfma_f32_16x16x32_bf16 v[12:15], v[104:107], v[72:75], v[12:15]
    s_waitcnt lgkmcnt(0)
    v_mfma_f32_16x16x32_bf16 v[12:15], v[108:111], v[76:79], v[12:15]
    s_nop 7
    s_nop 1
    v_lshlrev_b32 v8, 17, v2
    v_lshl_add_u32 v8, v3, 4, v8
    s_lshl_b32 s92, s76, 12
    s_lshl_b32 s93, s77, 9
    s_add_u32 s92, s92, s93
    s_lshl_b32 s93, s88, 7
    s_add_u32 s92, s92, s93
    s_add_u32 s92, s92, 1376256
    s_branch L_p9pub
L_p9e:
    v_mul_u32_u24 v7, 528, v9
    v_lshl_add_u32 v7, v3, 4, v7
    v_add_u32 v7, 67072, v7
    ds_read_b128 v[64:67], v7 offset:0
    ds_read_b128 v[68:71], v7 offset:64
    ds_read_b128 v[72:75], v7 offset:128
    ds_read_b128 v[76:79], v7 offset:192
    ds_read_b128 v[80:83], v7 offset:256
    ds_read_b128 v[84:87], v7 offset:320
    ds_read_b128 v[88:91], v7 offset:384
    s_waitcnt lgkmcnt(6)
    v_mfma_f32_16x16x32_bf16 v[12:15], v[96:99], v[64:67], 0
    s_waitcnt lgkmcnt(5)
    v_mfma_f32_16x16x32_bf16 v[12:15], v[100:103], v[68:71], v[12:15]
    s_waitcnt lgkmcnt(4)
    v_mfma_f32_16x16x32_bf16 v[12:15], v[104:107], v[72:75], v[12:15]
    s_waitcnt lgkmcnt(3)
    v_mfma_f32_16x16x32_bf16 v[12:15], v[108:111], v[76:79], v[12:15]
    s_waitcnt lgkmcnt(2)
    v_mfma_f32_16x16x32_bf16 v[12:15], v[112:115], v[80:83], v[12:15]
    s_waitcnt lgkmcnt(1)
    v_mfma_f32_16x16x32_bf16 v[12:15], v[116:119], v[84:87], v[12:15]
    s_waitcnt lgkmcnt(0)
    v_mfma_f32_16x16x32_bf16 v[12:15], v[120:123], v[88:91], v[12:15]
    s_nop 7
    s_nop 1
    v_lshlrev_b32 v8, 15, v2
    v_lshl_add_u32 v8, v3, 4, v8
    s_lshl_b32 s92, s98, 12
    s_lshl_b32 s93, s99, 7
    s_add_u32 s92, s92, s93
    s_add_u32 s92, s92, 2424832
L_p9pub:
    v_mov_b32 v16, v12
    v_mov_b32 v17, v4
    v_mov_b32 v18, v13
    v_mov_b32 v19, v4
    v_mov_b32 v20, v14
    v_mov_b32 v21, v4
    v_mov_b32 v22, v15
    v_mov_b32 v23, v4
    v_cmp_gt_u32 vcc, 8, v2
    s_and_saveexec_b64 s[84:85], vcc
    buffer_store_dwordx4 v[16:19], v8, s[64:67], s92 offen sc1
    buffer_store_dwordx4 v[20:23], v8, s[64:67], s92 offen offset:64 sc1
    s_mov_b64 exec, s[84:85]
    s_cmp_lg_u32 s68, 0
    s_cbranch_scc1 L_done
    v_lshrrev_b32 v8, 3, v1
    v_and_b32 v9, 7, v1
    v_lshlrev_b32 v10, 4, v9
    v_lshl_add_u32 v8, v8, 12, v10
    s_lshl_b32 s93, s101, 7
    s_lshl_b32 s92, s100, 17
    s_add_u32 s92, s92, s93
    s_add_u32 s92, s92, 1376256
    s_add_u32 s8, s92, 32768
    s_add_u32 s9, s92, 65536
    s_add_u32 s10, s92, 98304
    s_lshl_b32 s11, s100, 15
    s_add_u32 s11, s11, s93
    s_add_u32 s11, s11, 2424832
L_fretry:
    buffer_load_dwordx4 v[32:35], v8, s[64:67], s92 offen sc1
    buffer_load_dwordx4 v[36:39], v8, s[64:67], s8 offen sc1
    buffer_load_dwordx4 v[40:43], v8, s[64:67], s9 offen sc1
    buffer_load_dwordx4 v[44:47], v8, s[64:67], s10 offen sc1
    buffer_load_dwordx4 v[48:51], v8, s[64:67], s11 offen sc1
    s_waitcnt vmcnt(0)
    v_min_u32 v16, v33, v35
    v_max_u32 v17, v33, v35
    v_min3_u32 v16, v16, v37, v39
    v_max3_u32 v17, v17, v37, v39
    v_min3_u32 v16, v16, v41, v43
    v_max3_u32 v17, v17, v41, v43
    v_min3_u32 v16, v16, v45, v47
    v_max3_u32 v17, v17, v45, v47
    v_min3_u32 v16, v16, v49, v51
    v_max3_u32 v17, v17, v49, v51
    v_xor_b32 v16, v16, v4
    v_xor_b32 v17, v17, v4
    v_or_b32 v16, v16, v17
    v_cmp_ne_u32 vcc, 0, v16
    s_cbranch_vccz L_fretry_ok
    s_add_u32 s82, s82, 1
    s_cmp_lt_u32 s82, 1000000
    s_cbranch_scc1 L_fretry
L_fretry_ok:
    v_add_f32 v12, v32, v36
    v_add_f32 v13, v34, v38
    v_add_f32 v14, v40, v44
    v_add_f32 v15, v42, v46
    v_add_f32 v12, v12, v14
    v_add_f32 v13, v13, v15
    v_mov_b32 v14, v48
    v_mov_b32 v15, v50
    s_nop 1
    v_add_f32_dpp v12, v12, v12 row_ror:8 row_mask:0xf bank_mask:0xf
    v_add_f32_dpp v13, v13, v13 row_ror:8 row_mask:0xf bank_mask:0xf
    v_add_f32_dpp v14, v14, v14 row_ror:8 row_mask:0xf bank_mask:0xf
    v_add_f32_dpp v15, v15, v15 row_ror:8 row_mask:0xf bank_mask:0xf
    v_mov_b32 v16, v12
    v_mov_b32 v17, v13
    v_mov_b32 v18, v14
    v_mov_b32 v19, v15
    s_nop 1
    v_permlane16_swap_b32 v12, v16
    v_permlane16_swap_b32 v13, v17
    v_permlane16_swap_b32 v14, v18
    v_permlane16_swap_b32 v15, v19
    v_add_f32 v12, v12, v16
    v_add_f32 v13, v13, v17
    v_add_f32 v14, v14, v18
    v_add_f32 v15, v15, v19
    v_mov_b32 v16, v12
    v_mov_b32 v17, v13
    v_mov_b32 v18, v14
    v_mov_b32 v19, v15
    s_nop 1
    v_permlane32_swap_b32 v12, v16
    v_permlane32_swap_b32 v13, v17
    v_permlane32_swap_b32 v14, v18
    v_permlane32_swap_b32 v15, v19
    v_add_f32 v12, v12, v16
    v_add_f32 v13, v13, v17
    v_add_f32 v14, v14, v18
    v_add_f32 v15, v15, v19
    v_cvt_pk_bf16_f32 v12, v12, v13
    v_cvt_pk_bf16_f32 v14, v14, v15
    v_lshlrev_b32 v16, 16, v12
    v_and_b32 v17, 0xffff0000, v12
    v_lshlrev_b32 v18, 16, v14
    v_and_b32 v19, 0xffff0000, v14
    v_lshlrev_b32 v20, 16, v5
    v_and_b32 v21, 0xffff0000, v5
    v_mul_f32 v22, s86, v18
    v_mul_f32 v23, s86, v19
    v_exp_f32 v22, -v22
    v_exp_f32 v23, -v23
    s_nop 0
    v_add_f32 v22, 1.0, v22
    v_add_f32 v23, 1.0, v23
    v_rcp_f32 v24, v22
    v_rcp_f32 v25, v23
    s_nop 0
    v_mul_f32 v12, v18, v24
    v_fma_f32 v13, -v12, v22, v18
    v_fma_f32 v18, v13, v24, v12
    v_mul_f32 v12, v19, v25
    v_fma_f32 v13, -v12, v23, v19
    v_fma_f32 v19, v13, v25, v12
    v_cvt_pk_bf16_f32 v12, v18, v19
    v_lshlrev_b32 v18, 16, v12
    v_and_b32 v19, 0xffff0000, v12
    v_mul_f32 v18, v16, v18
    v_mul_f32 v19, v17, v19
    v_cvt_pk_bf16_f32 v12, v18, v19
    v_lshlrev_b32 v18, 16, v12
    v_and_b32 v19, 0xffff0000, v12
    v_add_f32 v18, v20, v18
    v_add_f32 v19, v21, v19
    v_cvt_pk_bf16_f32 v12, v18, v19
    v_and_b32 v27, 3, v1
    v_lshlrev_b32 v27, 3, v27
    v_bfe_u32 v13, v1, 2, 1
    v_lshl_add_u32 v27, v13, 2, v27
    s_mov_b64 exec, 0xff
    buffer_store_dword v12, v27, s[60:63], s74 offen
    s_cmp_lg_u32 s2, 0
    s_cbranch_scc1 L_done
    s_mov_b64 exec, 1
    buffer_store_dword v4, v31, s[64:67], 0 offen sc1
L_done:
L_end:
    s_endpgm
.section .rodata,"a"
.p2align 6
.amdhsa_kernel recurrent_scan__sliding_block_cached__glu_gated_bilinear__decode_kernel
  .amdhsa_next_free_vgpr 128
  .amdhsa_next_free_sgpr 102
  .amdhsa_accum_offset 128
  .amdhsa_group_segment_fixed_size 0
  .amdhsa_kernarg_size 96
  .amdhsa_user_sgpr_count 2
  .amdhsa_user_sgpr_kernarg_segment_ptr 1
  .amdhsa_system_sgpr_workgroup_id_x 1
.end_amdhsa_kernel
```
